```python
import torch

def _softmax(x, axis=-1):
    return torch.softmax(x, dim=axis)
def _gelu(x):
    return torch.nn.functional.gelu(x, approximate="tanh")
def _silu(x):
    return torch.nn.functional.silu(x)
def _sigmoid(x):
    return torch.sigmoid(x)
def _layernorm(x, axis=-1, eps=1e-5):
    m = x.mean(dim=axis, keepdim=True)
    v = x.var(dim=axis, keepdim=True, unbiased=False)
    return (x - m) / torch.sqrt(v + eps)
def _scatter_add(tgt, idx, src, axis=0):
    return tgt.clone().index_add_(axis, idx, src)
def _segment_sum(src, seg, n):
    out = torch.zeros((n,) + src.shape[1:], dtype=src.dtype)
    return out.index_add_(0, seg, src)
def _pad(x, pw):
    flat = tuple(v for pair in reversed(pw) for v in pair)
    return torch.nn.functional.pad(x, flat)

kernel_name = 'parallel_sum__gqa_block_cached__glu_gated_bilinear__decode'

def setup_inputs():

    _w = (lambda a: (lambda t: t.to(torch.bfloat16) if t.is_floating_point() else t)(torch.as_tensor(a)))
    def _A_setup():
        B, Sq, D = 4, 1, 512
        Hq, Hkv, Sk, Dh = 32, 8, 4096, 128
        assert Hq % Hkv == 0, (Hq, Hkv)
        return {
            "x": _w((lambda *s: torch.randn(*s, dtype=torch.bfloat16) * 0.05)(B, Sq, D)),
            "k_cache": _w((lambda *s: torch.randn(*s, dtype=torch.bfloat16) * 1.6)(B, Hkv, Sk, Dh)),
            "v_cache": _w((lambda *s: torch.randn(*s, dtype=torch.bfloat16) * 0.8)(B, Hkv, Sk, Dh)),
            "wq": _w((lambda *s: torch.randn(*s, dtype=torch.bfloat16) * 1.6)(D, Hq * Dh) * (D ** -0.5)),
            "wo": _w((lambda *s: torch.randn(*s, dtype=torch.bfloat16) * 0.8)(Hq * Dh, D) * ((Hq * Dh) ** -0.5)),
        }
    _A_in = _A_setup()

    def _B_setup():
        B, S, D, F = 4, 1, 512, 1792
        return {
            "x": _w((lambda *s: torch.randn(*s, dtype=torch.bfloat16) * 0.05)(B, S, D)),
            "w_gate": _w((lambda *s: torch.randn(*s, dtype=torch.bfloat16) * 0.4)(D, F) * (D ** -0.5)),
            "w_up": _w((lambda *s: torch.randn(*s, dtype=torch.bfloat16) * 0.4)(D, F) * (D ** -0.5)),
            "w_down": _w((lambda *s: torch.randn(*s, dtype=torch.bfloat16) * 0.4)(F, D) * (F ** -0.5)),
        }
    _B_in = _B_setup()

    return {
        "A_x": _A_in["x"],
        "A_k_cache": _A_in["k_cache"],
        "A_v_cache": _A_in["v_cache"],
        "A_wq": _A_in["wq"],
        "A_wo": _A_in["wo"],
        "B_x": _B_in["x"],
        "B_w_gate": _B_in["w_gate"],
        "B_w_up": _B_in["w_up"],
        "B_w_down": _B_in["w_down"],
    }

def reference(A_x, A_k_cache, A_v_cache, A_wq, A_wo, B_x, B_w_gate, B_w_up, B_w_down):
    def _A_ref(x, k_cache, v_cache, wq, wo):
        B, Sq, D = x.shape
        Hq, Dh = 32, 128
        Hkv = k_cache.shape[1]
        rep = Hq // Hkv
        q = (lambda x, *d: x.permute(*d))((x @ wq).reshape(B, Sq, Hq, Dh), 0, 2, 1, 3)
        k = (lambda x, n, axis: torch.repeat_interleave(x, n, dim=axis))(k_cache, rep, axis=1)
        v = (lambda x, n, axis: torch.repeat_interleave(x, n, dim=axis))(v_cache, rep, axis=1)
        scores = torch.einsum("bhqd,bhkd->bhqk", q, k) * (Dh ** -0.5)
        p = _softmax(scores, axis=-1)
        o = torch.einsum("bhqk,bhkd->bhqd", p, v)
        return (lambda x, *d: x.permute(*d))(o, 0, 2, 1, 3).reshape(B, Sq, Hq * Dh) @ wo

    def _B_ref(x, w_gate, w_up, w_down):
        g = torch.einsum("bsd,df->bsf", x, w_gate)
        u = torch.einsum("bsd,df->bsf", x, w_up)
        h = g * u
        return torch.einsum("bsf,fd->bsd", h, w_down)

    x = A_x
    xn = _layernorm(x, axis=-1)
    return x + _A_ref(xn, A_k_cache, A_v_cache, A_wq, A_wo) + _B_ref(xn, B_w_gate, B_w_up, B_w_down)
```

```asm
; @launch grid=(256,1,1) block=(640,1,1) lds=163840
.amdgcn_target "amdgcn-amd-amdhsa--gfx950"
.text
.globl parallel_sum__gqa_block_cached__glu_gated_bilinear__decode_kernel
.p2align 8
.type parallel_sum__gqa_block_cached__glu_gated_bilinear__decode_kernel,@function
parallel_sum__gqa_block_cached__glu_gated_bilinear__decode_kernel:
  s_cmp_ge_u32 s2, 256
  s_cbranch_scc1 L_end
  s_load_dwordx16 s[4:19], s[0:1], 0
  s_load_dwordx8 s[20:27], s[0:1], 64
  v_lshrrev_b32 v1, 6, v0
  v_and_b32 v0, 63, v0
  v_readfirstlane_b32 s28, v1
  s_and_b32 s29, s2, 7
  s_lshr_b32 s31, s2, 6
  s_bfe_u32 s32, s2, 0x30003
  s_lshl3_add_u32 s30, s31, s29
  v_lshrrev_b32 v1, 4, v0
  v_and_b32 v6, 1, v0
  s_cmp_ge_u32 s28, 1
  s_cbranch_scc1 L_other
  v_bfe_u32 v5, v0, 1, 3
  v_xor_b32 v5, v5, v1
  v_lshlrev_b32 v7, 4, v6
  v_lshl_add_u32 v7, v1, 8, v7
  v_lshl_add_u32 v15, v5, 5, v7
  s_lshl_b32 s36, s30, 20
  s_lshl_b32 s50, s32, 17
  s_mov_b32 s51, s50
  s_mov_b32 s57, 0
  v_xor_b32 v16, 0x80, v15
  s_lshl_b32 s37, s28, 11
  s_add_u32 s36, s36, s37
  s_mov_b32 m0, s37
  s_mov_b32 s58, 0x84000000
  s_mov_b32 s59, 0x80204100
  s_getpc_b64 s[46:47]
L_pc:
  s_and_b32 s48, s32, 3
  v_lshl_add_u32 v12, v0, 2, s48
  v_lshlrev_b32 v12, 7, v12
  v_cmp_gt_u32 vcc, L_codeend-L_pc-4, v12
  s_and_saveexec_b64 s[48:49], vcc
  global_load_dword v13, v12, s[46:47]
  s_mov_b64 exec, -1
L_npt:
  s_waitcnt lgkmcnt(0)
  s_add_u32 s42, s6, s36
  s_addc_u32 s43, s7, 0
  s_add_u32 s46, s8, s36
  s_addc_u32 s47, s9, 0
L_lg:
  s_add_u32 s44, s42, s51
  s_addc_u32 s45, s43, 0
  s_waitcnt vmcnt(23)
  global_load_lds_dwordx4 v15, s[44:45] offset:0 nt
  s_waitcnt vmcnt(23)
  global_load_lds_dwordx4 v16, s[44:45] offset:1024 nt
  s_waitcnt vmcnt(23)
  global_load_lds_dwordx4 v15, s[44:45] offset:2048 nt
  s_waitcnt vmcnt(23)
  global_load_lds_dwordx4 v16, s[44:45] offset:3072 nt
L_lgc:
  s_addk_i32 m0, 4096
  s_add_u32 s51, s51, 0x21000
  s_and_b32 s51, s51, 0xfffff
  s_bitcmp1_b64 s[58:59], s57
  s_cbranch_scc1 L_lb
  s_add_u32 s57, s57, 1
  s_branch L_lg
L_lb:
  s_add_u32 s57, s57, 1
  s_cmp_eq_u32 s57, 32
  s_cselect_b32 s42, s46, s42
  s_cselect_b32 s43, s47, s43
  s_cselect_b32 s51, s50, s51
  s_cselect_b32 m0, s37, m0
  s_barrier
  s_cmp_lt_u32 s57, 64
  s_cbranch_scc1 L_lg
  s_branch L_load2
L_other:
  s_lshl2_add_u32 s33, s29, s31
  v_and_b32 v3, 3, v0
  s_cmp_gt_u32 s28, 1
  s_cbranch_scc1 L_comp
  v_lshrrev_b32 v4, 5, v0
  v_bfe_u32 v5, v0, 3, 2
  v_lshl_add_u32 v4, v4, 3, v5
  v_bfe_u32 v5, v0, 1, 2
  v_xor_b32 v5, v5, v1
  v_lshlrev_b32 v7, 4, v6
  v_lshl_add_u32 v5, v5, 5, v7
  s_lshl_b32 s35, s32, 7
  v_lshl_add_u32 v8, v4, 13, v5
  v_add_u32 v9, 130048, v8
  v_add_u32 v10, 30720, v8
  v_add_u32 v11, 160768, v8
  v_lshlrev_b32 v36, 10, v3
  v_lshl_add_u32 v36, v1, 4, v36
  v_bfe_u32 v2, v0, 2, 1
  v_lshl_add_u32 v37, v2, 6, v36
  v_bfe_u32 v2, v0, 2, 2
  v_lshl_add_u32 v36, v2, 6, v36
  s_lshl_b32 s34, s31, 8
  v_add_u32 v36, s34, v36
  v_add_u32 v37, s35, v37
  v_xor_b32 v38, 0x100, v36
  v_xor_b32 v39, 0x200, v36
  v_xor_b32 v40, 0x300, v36
  s_lshl_b32 s36, s31, 20
  s_lshl_b32 s37, s29, 10
  s_add_u32 s36, s36, s37
  s_add_u32 s36, s36, s35
  s_mov_b32 m0, 131072
  s_waitcnt lgkmcnt(0)
  s_load_dwordx2 s[64:65], s[26:27], 0
  global_load_dwordx4 v[16:19], v36, s[4:5]
  global_load_dwordx4 v[20:23], v38, s[4:5]
  global_load_dwordx4 v[24:27], v39, s[4:5]
  global_load_dwordx4 v[28:31], v40, s[4:5]
  global_load_dwordx4 v[32:35], v37, s[4:5]
  s_add_u32 s40, s10, s36
  s_addc_u32 s41, s11, 0
  global_load_lds_dwordx4 v8, s[40:41] offset:0 nt
  global_load_lds_dwordx4 v9, s[40:41] offset:1024 nt
  global_load_lds_dwordx4 v10, s[40:41] offset:2048 nt
  global_load_lds_dwordx4 v11, s[40:41] offset:3072 nt
  s_addk_i32 m0, 4096
  s_add_u32 s40, s40, 262144
  s_addc_u32 s41, s41, 0
  global_load_lds_dwordx4 v8, s[40:41] offset:0 nt
  global_load_lds_dwordx4 v9, s[40:41] offset:1024 nt
  global_load_lds_dwordx4 v10, s[40:41] offset:2048 nt
  global_load_lds_dwordx4 v11, s[40:41] offset:3072 nt
  s_addk_i32 m0, 4096
  s_add_u32 s40, s40, 262144
  s_addc_u32 s41, s41, 0
  global_load_lds_dwordx4 v8, s[40:41] offset:0 nt
  global_load_lds_dwordx4 v9, s[40:41] offset:1024 nt
  global_load_lds_dwordx4 v10, s[40:41] offset:2048 nt
  global_load_lds_dwordx4 v11, s[40:41] offset:3072 nt
  s_addk_i32 m0, 4096
  s_add_u32 s40, s40, 262144
  s_addc_u32 s41, s41, 0
  global_load_lds_dwordx4 v8, s[40:41] offset:0 nt
  global_load_lds_dwordx4 v9, s[40:41] offset:1024 nt
  global_load_lds_dwordx4 v10, s[40:41] offset:2048 nt
  global_load_lds_dwordx4 v11, s[40:41] offset:3072 nt
  s_getreg_b32 s51, hwreg(HW_REG_XCC_ID, 0, 4)
  s_lshl_b32 s51, s51, 16
  s_lshl_b32 s46, s2, 7
  s_add_u32 s46, s46, 0x1c0000
  v_mov_b32 v12, s46
  s_waitcnt lgkmcnt(0)
  s_add_u32 s64, s64, 0x7f4a7c15
  s_addc_u32 s65, s65, 0x9e3779b9
  s_and_b32 s60, s64, 1023
  s_bfe_u32 s61, s64, 0xa000a
  s_bfe_u32 s62, s64, 0xa0014
  s_and_b32 s63, s65, 1023
  v_mov_b32 v123, 0xfffffc00
  s_add_u32 s68, s26, 0x400000
  s_addc_u32 s69, s27, 0
  s_bfe_u32 s86, s64, 0x60000
  s_bfe_u32 s87, s64, 0x60006
  s_bfe_u32 s88, s64, 0x6000c
  s_bfe_u32 s89, s64, 0x60012
  v_mov_b32 v122, 0xffffffc0
  v_mov_b32 v8, s51
  v_mov_b32 v9, s51
  v_mov_b32 v10, s51
  v_mov_b32 v11, s51
  v_and_or_b32 v8, v8, v123, s60
  v_and_or_b32 v9, v9, v123, s61
  v_and_or_b32 v10, v10, v123, s62
  v_and_or_b32 v11, v11, v123, s63
  s_mov_b64 exec, 1
  global_store_dwordx4 v12, v[8:11], s[26:27] sc1
  s_mov_b64 exec, -1
  s_cmp_ge_u32 s30, 28
  s_cbranch_scc1 L_noffn1
  v_mov_b32 v13, 3584
  v_mad_u32_u24 v12, v4, v13, v5
  v_add_u32 v13, 56320, v12
  v_add_u32 v14, 12288, v12
  v_add_u32 v15, 68608, v12
  s_mul_i32 s38, s32, 229376
  s_lshl_b32 s39, s30, 7
  s_add_u32 s38, s38, s39
  s_addk_i32 m0, 4096
  s_add_u32 s40, s16, s38
  s_addc_u32 s41, s17, 0
  global_load_lds_dwordx4 v12, s[40:41] offset:0 nt
  global_load_lds_dwordx4 v13, s[40:41] offset:1024 nt
  global_load_lds_dwordx4 v14, s[40:41] offset:2048 nt
  global_load_lds_dwordx4 v15, s[40:41] offset:3072 nt
  s_addk_i32 m0, 4096
  s_add_u32 s40, s40, 114688
  s_addc_u32 s41, s41, 0
  global_load_lds_dwordx4 v12, s[40:41] offset:0 nt
  global_load_lds_dwordx4 v13, s[40:41] offset:1024 nt
  global_load_lds_dwordx4 v14, s[40:41] offset:2048 nt
  global_load_lds_dwordx4 v15, s[40:41] offset:3072 nt
  s_addk_i32 m0, 4096
  s_add_u32 s40, s18, s38
  s_addc_u32 s41, s19, 0
  global_load_lds_dwordx4 v12, s[40:41] offset:0 nt
  global_load_lds_dwordx4 v13, s[40:41] offset:1024 nt
  global_load_lds_dwordx4 v14, s[40:41] offset:2048 nt
  global_load_lds_dwordx4 v15, s[40:41] offset:3072 nt
  s_addk_i32 m0, 4096
  s_add_u32 s40, s40, 114688
  s_addc_u32 s41, s41, 0
  global_load_lds_dwordx4 v12, s[40:41] offset:0 nt
  global_load_lds_dwordx4 v13, s[40:41] offset:1024 nt
  global_load_lds_dwordx4 v14, s[40:41] offset:2048 nt
  global_load_lds_dwordx4 v15, s[40:41] offset:3072 nt
  s_waitcnt vmcnt(33)
  s_branch L_wx1
L_noffn1:
  s_waitcnt vmcnt(17)
L_wx1:
  s_mov_b32 s52, 0xffff0000
  v_lshlrev_b32 v40, 16, v16
  v_and_b32 v41, s52, v16
  v_lshlrev_b32 v42, 16, v17
  v_and_b32 v43, s52, v17
  v_lshlrev_b32 v44, 16, v18
  v_and_b32 v45, s52, v18
  v_lshlrev_b32 v46, 16, v19
  v_and_b32 v47, s52, v19
  v_lshlrev_b32 v48, 16, v20
  v_and_b32 v49, s52, v20
  v_lshlrev_b32 v50, 16, v21
  v_and_b32 v51, s52, v21
  v_lshlrev_b32 v52, 16, v22
  v_and_b32 v53, s52, v22
  v_lshlrev_b32 v54, 16, v23
  v_and_b32 v55, s52, v23
  v_lshlrev_b32 v56, 16, v24
  v_and_b32 v57, s52, v24
  v_lshlrev_b32 v58, 16, v25
  v_and_b32 v59, s52, v25
  v_lshlrev_b32 v60, 16, v26
  v_and_b32 v61, s52, v26
  v_lshlrev_b32 v62, 16, v27
  v_and_b32 v63, s52, v27
  v_lshlrev_b32 v64, 16, v28
  v_and_b32 v65, s52, v28
  v_lshlrev_b32 v66, 16, v29
  v_and_b32 v67, s52, v29
  v_lshlrev_b32 v68, 16, v30
  v_and_b32 v69, s52, v30
  v_lshlrev_b32 v70, 16, v31
  v_and_b32 v71, s52, v31
  v_lshlrev_b32 v72, 16, v32
  v_and_b32 v73, s52, v32
  v_lshlrev_b32 v74, 16, v33
  v_and_b32 v75, s52, v33
  v_lshlrev_b32 v76, 16, v34
  v_and_b32 v77, s52, v34
  v_lshlrev_b32 v78, 16, v35
  v_and_b32 v79, s52, v35
  v_pk_add_f32 v[80:81], v[40:41], v[56:57]
  v_pk_add_f32 v[82:83], v[42:43], v[58:59]
  v_pk_add_f32 v[84:85], v[44:45], v[60:61]
  v_pk_add_f32 v[86:87], v[46:47], v[62:63]
  v_pk_add_f32 v[88:89], v[48:49], v[64:65]
  v_pk_add_f32 v[90:91], v[50:51], v[66:67]
  v_pk_add_f32 v[92:93], v[52:53], v[68:69]
  v_pk_add_f32 v[94:95], v[54:55], v[70:71]
  v_pk_add_f32 v[80:81], v[80:81], v[88:89]
  v_pk_add_f32 v[82:83], v[82:83], v[90:91]
  v_pk_add_f32 v[84:85], v[84:85], v[92:93]
  v_pk_add_f32 v[86:87], v[86:87], v[94:95]
  v_pk_add_f32 v[80:81], v[80:81], v[84:85]
  v_pk_add_f32 v[82:83], v[82:83], v[86:87]
  v_pk_add_f32 v[80:81], v[80:81], v[82:83]
  v_add_f32 v80, v80, v81
  s_nop 1
  v_add_f32_dpp v80, v80, v80 row_ror:4 row_mask:0xf bank_mask:0xf
  s_nop 1
  v_add_f32_dpp v80, v80, v80 row_ror:8 row_mask:0xf bank_mask:0xf
  v_mov_b32 v81, v80
  s_nop 1
  v_permlane16_swap_b32 v80, v81
  s_nop 0
  v_add_f32 v80, v80, v81
  v_mov_b32 v81, v80
  s_nop 1
  v_permlane32_swap_b32 v80, v81
  s_nop 0
  v_add_f32 v80, v80, v81
  v_mul_f32 v80, 0xbb000000, v80
  v_mov_b32 v81, v80
  v_pk_add_f32 v[84:85], v[40:41], v[80:81]
  v_pk_add_f32 v[86:87], v[42:43], v[80:81]
  v_pk_add_f32 v[88:89], v[44:45], v[80:81]
  v_pk_add_f32 v[90:91], v[46:47], v[80:81]
  v_pk_add_f32 v[92:93], v[48:49], v[80:81]
  v_pk_add_f32 v[94:95], v[50:51], v[80:81]
  v_pk_add_f32 v[96:97], v[52:53], v[80:81]
  v_pk_add_f32 v[98:99], v[54:55], v[80:81]
  v_pk_add_f32 v[100:101], v[56:57], v[80:81]
  v_pk_add_f32 v[102:103], v[58:59], v[80:81]
  v_pk_add_f32 v[104:105], v[60:61], v[80:81]
  v_pk_add_f32 v[106:107], v[62:63], v[80:81]
  v_pk_add_f32 v[108:109], v[64:65], v[80:81]
  v_pk_add_f32 v[110:111], v[66:67], v[80:81]
  v_pk_add_f32 v[112:113], v[68:69], v[80:81]
  v_pk_add_f32 v[114:115], v[70:71], v[80:81]
  v_pk_mul_f32 v[82:83], v[84:85], v[84:85]
  v_pk_mul_f32 v[116:117], v[86:87], v[86:87]
  v_pk_fma_f32 v[82:83], v[88:89], v[88:89], v[82:83]
  v_pk_fma_f32 v[116:117], v[90:91], v[90:91], v[116:117]
  v_pk_fma_f32 v[82:83], v[92:93], v[92:93], v[82:83]
  v_pk_fma_f32 v[116:117], v[94:95], v[94:95], v[116:117]
  v_pk_fma_f32 v[82:83], v[96:97], v[96:97], v[82:83]
  v_pk_fma_f32 v[116:117], v[98:99], v[98:99], v[116:117]
  v_pk_fma_f32 v[82:83], v[100:101], v[100:101], v[82:83]
  v_pk_fma_f32 v[116:117], v[102:103], v[102:103], v[116:117]
  v_pk_fma_f32 v[82:83], v[104:105], v[104:105], v[82:83]
  v_pk_fma_f32 v[116:117], v[106:107], v[106:107], v[116:117]
  v_pk_fma_f32 v[82:83], v[108:109], v[108:109], v[82:83]
  v_pk_fma_f32 v[116:117], v[110:111], v[110:111], v[116:117]
  v_pk_fma_f32 v[82:83], v[112:113], v[112:113], v[82:83]
  v_pk_fma_f32 v[116:117], v[114:115], v[114:115], v[116:117]
  v_pk_add_f32 v[82:83], v[82:83], v[116:117]
  v_add_f32 v82, v82, v83
  s_nop 1
  v_add_f32_dpp v82, v82, v82 row_ror:4 row_mask:0xf bank_mask:0xf
  s_nop 1
  v_add_f32_dpp v82, v82, v82 row_ror:8 row_mask:0xf bank_mask:0xf
  v_mov_b32 v83, v82
  s_nop 1
  v_permlane16_swap_b32 v82, v83
  s_nop 0
  v_add_f32 v82, v82, v83
  v_mov_b32 v83, v82
  s_nop 1
  v_permlane32_swap_b32 v82, v83
  s_nop 0
  v_add_f32 v82, v82, v83
  v_mul_f32 v82, 0x3b000000, v82
  v_cvt_pk_bf16_f32 v80, v80, v82
  v_and_b32 v82, s52, v80
  v_lshlrev_b32 v80, 16, v80
  v_add_f32 v82, 0x3727c5ac, v82
  v_cvt_pk_bf16_f32 v82, v82, v82
  v_and_b32 v82, s52, v82
  v_sqrt_f32 v82, v82
  v_mov_b32 v81, v80
  v_cvt_pk_bf16_f32 v82, v82, v82
  v_and_b32 v82, s52, v82
  v_rcp_f32 v82, v82
  v_pk_add_f32 v[40:41], v[40:41], v[80:81]
  v_pk_add_f32 v[42:43], v[42:43], v[80:81]
  v_pk_add_f32 v[44:45], v[44:45], v[80:81]
  v_pk_add_f32 v[46:47], v[46:47], v[80:81]
  v_pk_add_f32 v[72:73], v[72:73], v[80:81]
  v_pk_add_f32 v[74:75], v[74:75], v[80:81]
  v_pk_add_f32 v[76:77], v[76:77], v[80:81]
  v_pk_add_f32 v[78:79], v[78:79], v[80:81]
  v_mov_b32 v83, v82
  v_cvt_pk_bf16_f32 v16, v40, v41
  v_cvt_pk_bf16_f32 v17, v42, v43
  v_cvt_pk_bf16_f32 v18, v44, v45
  v_cvt_pk_bf16_f32 v19, v46, v47
  v_cvt_pk_bf16_f32 v32, v72, v73
  v_cvt_pk_bf16_f32 v33, v74, v75
  v_cvt_pk_bf16_f32 v34, v76, v77
  v_cvt_pk_bf16_f32 v35, v78, v79
  v_lshlrev_b32 v40, 16, v16
  v_and_b32 v41, s52, v16
  v_lshlrev_b32 v42, 16, v17
  v_and_b32 v43, s52, v17
  v_lshlrev_b32 v44, 16, v18
  v_and_b32 v45, s52, v18
  v_lshlrev_b32 v46, 16, v19
  v_and_b32 v47, s52, v19
  v_lshlrev_b32 v72, 16, v32
  v_and_b32 v73, s52, v32
  v_lshlrev_b32 v74, 16, v33
  v_and_b32 v75, s52, v33
  v_lshlrev_b32 v76, 16, v34
  v_and_b32 v77, s52, v34
  v_lshlrev_b32 v78, 16, v35
  v_and_b32 v79, s52, v35
  v_pk_mul_f32 v[40:41], v[40:41], v[82:83]
  v_pk_mul_f32 v[42:43], v[42:43], v[82:83]
  v_pk_mul_f32 v[44:45], v[44:45], v[82:83]
  v_pk_mul_f32 v[46:47], v[46:47], v[82:83]
  v_pk_mul_f32 v[72:73], v[72:73], v[82:83]
  v_pk_mul_f32 v[74:75], v[74:75], v[82:83]
  v_pk_mul_f32 v[76:77], v[76:77], v[82:83]
  v_pk_mul_f32 v[78:79], v[78:79], v[82:83]
  v_cvt_pk_bf16_f32 v16, v40, v41
  v_cvt_pk_bf16_f32 v17, v42, v43
  v_cvt_pk_bf16_f32 v18, v44, v45
  v_cvt_pk_bf16_f32 v19, v46, v47
  v_cvt_pk_bf16_f32 v32, v72, v73
  v_cvt_pk_bf16_f32 v33, v74, v75
  v_cvt_pk_bf16_f32 v34, v76, v77
  v_cvt_pk_bf16_f32 v35, v78, v79
  v_mov_b32_dpp v20, v16 row_shl:4 row_mask:0xf bank_mask:0xf bound_ctrl:0
  v_mov_b32_dpp v21, v17 row_shl:4 row_mask:0xf bank_mask:0xf bound_ctrl:0
  v_mov_b32_dpp v22, v18 row_shl:4 row_mask:0xf bank_mask:0xf bound_ctrl:0
  v_mov_b32_dpp v23, v19 row_shl:4 row_mask:0xf bank_mask:0xf bound_ctrl:0
  v_mov_b32_dpp v24, v16 row_shl:8 row_mask:0xf bank_mask:0xf bound_ctrl:0
  v_mov_b32_dpp v25, v17 row_shl:8 row_mask:0xf bank_mask:0xf bound_ctrl:0
  v_mov_b32_dpp v26, v18 row_shl:8 row_mask:0xf bank_mask:0xf bound_ctrl:0
  v_mov_b32_dpp v27, v19 row_shl:8 row_mask:0xf bank_mask:0xf bound_ctrl:0
  v_mov_b32_dpp v28, v16 row_shl:12 row_mask:0xf bank_mask:0xf bound_ctrl:0
  v_mov_b32_dpp v29, v17 row_shl:12 row_mask:0xf bank_mask:0xf bound_ctrl:0
  v_mov_b32_dpp v30, v18 row_shl:12 row_mask:0xf bank_mask:0xf bound_ctrl:0
  v_mov_b32_dpp v31, v19 row_shl:12 row_mask:0xf bank_mask:0xf bound_ctrl:0
  v_mov_b32_dpp v36, v32 row_shl:4 row_mask:0xf bank_mask:0xf bound_ctrl:0
  v_mov_b32_dpp v37, v33 row_shl:4 row_mask:0xf bank_mask:0xf bound_ctrl:0
  v_mov_b32_dpp v38, v34 row_shl:4 row_mask:0xf bank_mask:0xf bound_ctrl:0
  v_mov_b32_dpp v39, v35 row_shl:4 row_mask:0xf bank_mask:0xf bound_ctrl:0
  v_bfe_u32 v8, v0, 3, 2
  v_lshlrev_b32 v8, 5, v8
  v_lshrrev_b32 v9, 2, v0
  v_lshl_add_u32 v8, v9, 7, v8
  v_lshl_add_u32 v8, v3, 3, v8
  v_add_u32 v8, 131072, v8
  v_xor_b32 v9, 32, v8
  v_xor_b32 v10, 64, v8
  v_xor_b32 v11, 96, v8
  v_lshlrev_b32 v5, 6, v2
  v_lshl_add_u32 v5, v1, 4, v5
  s_lshl_b32 s46, s29, 15
  s_lshl_b32 s47, s31, 11
  s_add_u32 s47, s47, s46
  s_lshl_b32 s44, s32, 8
  s_add_u32 s47, s47, s44
  s_add_u32 s47, s47, 65536
  v_lshl_add_u32 v5, v3, 13, v5
  v_add_u32 v5, s47, v5
  v_and_b32 v12, 31, v0
  v_lshl_add_u32 v12, v12, 3, s29
  v_lshlrev_b32 v12, 7, v12
  v_add_u32 v12, 0x1c0000, v12
  s_cmp_ge_u32 s30, 28
  s_cbranch_scc0 L_wq1
  s_waitcnt vmcnt(1)
L_wq1:
  s_waitcnt vmcnt(17)
  ds_read_b64_tr_b16 v[88:89], v8 offset:0
  ds_read_b64_tr_b16 v[90:91], v8 offset:2048
  ds_read_b64_tr_b16 v[92:93], v9 offset:0
  ds_read_b64_tr_b16 v[94:95], v9 offset:2048
  ds_read_b64_tr_b16 v[96:97], v10 offset:0
  ds_read_b64_tr_b16 v[98:99], v10 offset:2048
  ds_read_b64_tr_b16 v[100:101], v11 offset:0
  ds_read_b64_tr_b16 v[102:103], v11 offset:2048
  ds_read_b64_tr_b16 v[104:105], v8 offset:4096
  ds_read_b64_tr_b16 v[106:107], v8 offset:6144
  s_waitcnt lgkmcnt(8)
  v_mfma_f32_16x16x32_bf16 v[40:43], v[88:91], v[16:19], 0
  ds_read_b64_tr_b16 v[108:109], v9 offset:4096
  ds_read_b64_tr_b16 v[110:111], v9 offset:6144
  s_waitcnt lgkmcnt(8)
  v_mfma_f32_16x16x32_bf16 v[44:47], v[92:95], v[16:19], 0
  ds_read_b64_tr_b16 v[88:89], v10 offset:4096
  ds_read_b64_tr_b16 v[90:91], v10 offset:6144
  s_waitcnt lgkmcnt(8)
  v_mfma_f32_16x16x32_bf16 v[48:51], v[96:99], v[16:19], 0
  ds_read_b64_tr_b16 v[92:93], v11 offset:4096
  ds_read_b64_tr_b16 v[94:95], v11 offset:6144
  s_waitcnt lgkmcnt(8)
  v_mfma_f32_16x16x32_bf16 v[52:55], v[100:103], v[16:19], 0
  ds_read_b64_tr_b16 v[96:97], v8 offset:8192
  ds_read_b64_tr_b16 v[98:99], v8 offset:10240
  s_waitcnt lgkmcnt(8)
  v_mfma_f32_16x16x32_bf16 v[40:43], v[104:107], v[20:23], v[40:43]
  ds_read_b64_tr_b16 v[100:101], v9 offset:8192
  ds_read_b64_tr_b16 v[102:103], v9 offset:10240
  s_waitcnt lgkmcnt(8)
  v_mfma_f32_16x16x32_bf16 v[44:47], v[108:111], v[20:23], v[44:47]
  ds_read_b64_tr_b16 v[104:105], v10 offset:8192
  ds_read_b64_tr_b16 v[106:107], v10 offset:10240
  s_waitcnt lgkmcnt(8)
  v_mfma_f32_16x16x32_bf16 v[48:51], v[88:91], v[20:23], v[48:51]
  ds_read_b64_tr_b16 v[108:109], v11 offset:8192
  ds_read_b64_tr_b16 v[110:111], v11 offset:10240
  s_waitcnt lgkmcnt(8)
  v_mfma_f32_16x16x32_bf16 v[52:55], v[92:95], v[20:23], v[52:55]
  ds_read_b64_tr_b16 v[88:89], v8 offset:12288
  ds_read_b64_tr_b16 v[90:91], v8 offset:14336
  s_waitcnt lgkmcnt(8)
  v_mfma_f32_16x16x32_bf16 v[40:43], v[96:99], v[24:27], v[40:43]
  ds_read_b64_tr_b16 v[92:93], v9 offset:12288
  ds_read_b64_tr_b16 v[94:95], v9 offset:14336
  s_waitcnt lgkmcnt(8)
  v_mfma_f32_16x16x32_bf16 v[44:47], v[100:103], v[24:27], v[44:47]
  ds_read_b64_tr_b16 v[96:97], v10 offset:12288
  ds_read_b64_tr_b16 v[98:99], v10 offset:14336
  s_waitcnt lgkmcnt(8)
  v_mfma_f32_16x16x32_bf16 v[48:51], v[104:107], v[24:27], v[48:51]
  ds_read_b64_tr_b16 v[100:101], v11 offset:12288
  ds_read_b64_tr_b16 v[102:103], v11 offset:14336
  s_waitcnt lgkmcnt(8)
  v_mfma_f32_16x16x32_bf16 v[52:55], v[108:111], v[24:27], v[52:55]
  s_waitcnt lgkmcnt(6)
  v_mfma_f32_16x16x32_bf16 v[40:43], v[88:91], v[28:31], v[40:43]
  s_waitcnt lgkmcnt(4)
  v_mfma_f32_16x16x32_bf16 v[44:47], v[92:95], v[28:31], v[44:47]
  s_waitcnt lgkmcnt(2)
  v_mfma_f32_16x16x32_bf16 v[48:51], v[96:99], v[28:31], v[48:51]
  s_waitcnt lgkmcnt(0)
  v_mfma_f32_16x16x32_bf16 v[52:55], v[100:103], v[28:31], v[52:55]
  s_nop 7
  v_mov_b32_dpp v40, v44 row_shr:4 row_mask:0xf bank_mask:0x2
  v_mov_b32_dpp v41, v45 row_shr:4 row_mask:0xf bank_mask:0x2
  v_mov_b32_dpp v42, v46 row_shr:4 row_mask:0xf bank_mask:0x2
  v_mov_b32_dpp v43, v47 row_shr:4 row_mask:0xf bank_mask:0x2
  v_mov_b32_dpp v40, v48 row_shr:8 row_mask:0xf bank_mask:0x4
  v_mov_b32_dpp v41, v49 row_shr:8 row_mask:0xf bank_mask:0x4
  v_mov_b32_dpp v42, v50 row_shr:8 row_mask:0xf bank_mask:0x4
  v_mov_b32_dpp v43, v51 row_shr:8 row_mask:0xf bank_mask:0x4
  v_mov_b32_dpp v40, v52 row_shr:12 row_mask:0xf bank_mask:0x8
  v_mov_b32_dpp v41, v53 row_shr:12 row_mask:0xf bank_mask:0x8
  v_mov_b32_dpp v42, v54 row_shr:12 row_mask:0xf bank_mask:0x8
  v_mov_b32_dpp v43, v55 row_shr:12 row_mask:0xf bank_mask:0x8
  v_and_or_b32 v40, v40, v122, s86
  v_and_or_b32 v41, v41, v122, s87
  v_and_or_b32 v42, v42, v122, s88
  v_and_or_b32 v43, v43, v122, s89
  global_store_dwordx4 v5, v[40:43], s[68:69]
  global_load_dwordx4 v[44:47], v12, s[26:27] sc1
  v_lshlrev_b32 v112, 4, v0
  s_lshl3_add_u32 s3, s31, s29
  s_lshl3_add_u32 s3, s3, s32
  s_lshl_b32 s42, s3, 4
  v_lshl_add_u32 v113, v6, 3, s42
  v_lshl_add_u32 v113, v1, 1, v113
  global_load_ushort v7, v113, s[4:5]
  s_lshl_b32 s47, s31, 13
  s_add_u32 s46, s46, s47
  s_add_u32 s46, s46, 65536
  v_add_u32 v114, s46, v112
  s_lshl_b32 s48, s30, 14
  s_add_u32 s48, s48, 524288
  s_lshl_b32 s49, s32, 11
  s_add_u32 s49, s49, s48
  v_lshrrev_b32 v4, 1, v1
  v_lshl_add_u32 v4, v2, 1, v4
  v_lshlrev_b32 v4, 8, v4
  v_lshl_add_u32 v4, v3, 5, v4
  v_and_b32 v13, 1, v1
  v_lshl_add_u32 v4, v13, 4, v4
  v_add_u32 v4, s49, v4
  v_and_b32 v116, 0xf0, v112
  v_lshl_add_u32 v116, v1, 11, v116
  s_add_u32 s48, s48, s44
  v_add_u32 v116, s48, v116
  s_sub_u32 s46, s30, 8
  s_cmp_ge_u32 s30, 28
  s_cselect_b32 s46, s46, s30
  s_lshl_b32 s46, s46, 10
  s_add_u32 s46, s46, 4096
  v_add_u32 v118, s46, v112
  v_add_u32 v119, s35, v118
  s_lshl3_add_u32 s43, s33, s32
  s_lshl_b32 s46, s43, 7
  s_add_u32 s46, s46, 32768
  v_add_u32 v120, s46, v112
  v_lshlrev_b32 v124, 3, v0
  v_add_u32 v124, 159744, v124
  v_bfe_u32 v125, v0, 1, 2
  v_lshlrev_b32 v125, 7, v125
  v_lshrrev_b32 v13, 3, v0
  v_lshl_add_u32 v125, v13, 4, v125
  v_lshl_add_u32 v125, v6, 3, v125
  v_add_u32 v125, 160768, v125
  v_lshlrev_b32 v126, 5, v3
  v_add_u32 v126, 162304, v126
  s_lshl_b32 s46, s29, 15
  s_bfe_u32 s47, s3, 0x20001
  s_lshl_b32 s47, s47, 8
  s_add_u32 s46, s46, s47
  s_lshl_b32 s47, s31, 6
  s_add_u32 s46, s46, s47
  s_and_b32 s47, s3, 1
  s_lshl_b32 s47, s47, 5
  s_add_u32 s46, s46, s47
  s_add_u32 s46, s46, 1572864
  v_lshrrev_b32 v127, 1, v0
  v_lshlrev_b32 v127, 10, v127
  v_lshl_add_u32 v127, v6, 4, v127
  v_add_u32 v127, s46, v127
  s_lshl_b32 s46, s29, 12
  s_lshl4_add_u32 s46, s31, s46
  s_add_u32 s46, s46, 32768
  v_lshlrev_b32 v15, 10, v2
  v_lshl_add_u32 v15, v1, 7, v15
  v_add_u32 v15, s46, v15
  s_mov_b32 s50, 0x3fb8aa3b
  s_cmp_ge_u32 s30, 28
  s_cbranch_scc1 L_noffn2
  s_waitcnt vmcnt(3)
  ds_read_b64_tr_b16 v[88:89], v8 offset:16384
  ds_read_b64_tr_b16 v[90:91], v8 offset:18432
  ds_read_b64_tr_b16 v[92:93], v9 offset:16384
  ds_read_b64_tr_b16 v[94:95], v9 offset:18432
  ds_read_b64_tr_b16 v[96:97], v10 offset:16384
  ds_read_b64_tr_b16 v[98:99], v10 offset:18432
  ds_read_b64_tr_b16 v[100:101], v11 offset:16384
  ds_read_b64_tr_b16 v[102:103], v11 offset:18432
  ds_read_b64_tr_b16 v[104:105], v8 offset:20480
  ds_read_b64_tr_b16 v[106:107], v8 offset:22528
  s_waitcnt lgkmcnt(8)
  v_mfma_f32_16x16x32_bf16 v[56:59], v[88:91], v[32:35], 0
  ds_read_b64_tr_b16 v[108:109], v9 offset:20480
  ds_read_b64_tr_b16 v[110:111], v9 offset:22528
  s_waitcnt lgkmcnt(8)
  v_mfma_f32_16x16x32_bf16 v[60:63], v[92:95], v[32:35], 0
  ds_read_b64_tr_b16 v[88:89], v10 offset:20480
  ds_read_b64_tr_b16 v[90:91], v10 offset:22528
  s_waitcnt lgkmcnt(8)
  v_mfma_f32_16x16x32_bf16 v[64:67], v[96:99], v[32:35], 0
  ds_read_b64_tr_b16 v[92:93], v11 offset:20480
  ds_read_b64_tr_b16 v[94:95], v11 offset:22528
  s_waitcnt lgkmcnt(8)
  v_mfma_f32_16x16x32_bf16 v[68:71], v[100:103], v[32:35], 0
  ds_read_b64_tr_b16 v[96:97], v8 offset:24576
  ds_read_b64_tr_b16 v[98:99], v8 offset:26624
  s_waitcnt lgkmcnt(8)
  v_mfma_f32_16x16x32_bf16 v[56:59], v[104:107], v[36:39], v[56:59]
  ds_read_b64_tr_b16 v[100:101], v9 offset:24576
  ds_read_b64_tr_b16 v[102:103], v9 offset:26624
  s_waitcnt lgkmcnt(8)
  v_mfma_f32_16x16x32_bf16 v[60:63], v[108:111], v[36:39], v[60:63]
  ds_read_b64_tr_b16 v[104:105], v10 offset:24576
  ds_read_b64_tr_b16 v[106:107], v10 offset:26624
  s_waitcnt lgkmcnt(8)
  v_mfma_f32_16x16x32_bf16 v[64:67], v[88:91], v[36:39], v[64:67]
  ds_read_b64_tr_b16 v[108:109], v11 offset:24576
  ds_read_b64_tr_b16 v[110:111], v11 offset:26624
  s_waitcnt lgkmcnt(8)
  v_mfma_f32_16x16x32_bf16 v[68:71], v[92:95], v[36:39], v[68:71]
  ds_read_b64_tr_b16 v[88:89], v8 offset:28672
  ds_read_b64_tr_b16 v[90:91], v8 offset:30720
  s_waitcnt lgkmcnt(8)
  v_mfma_f32_16x16x32_bf16 v[72:75], v[96:99], v[32:35], 0
  ds_read_b64_tr_b16 v[92:93], v9 offset:28672
  ds_read_b64_tr_b16 v[94:95], v9 offset:30720
  s_waitcnt lgkmcnt(8)
  v_mfma_f32_16x16x32_bf16 v[76:79], v[100:103], v[32:35], 0
  ds_read_b64_tr_b16 v[96:97], v10 offset:28672
  ds_read_b64_tr_b16 v[98:99], v10 offset:30720
  s_waitcnt lgkmcnt(8)
  v_mfma_f32_16x16x32_bf16 v[80:83], v[104:107], v[32:35], 0
  ds_read_b64_tr_b16 v[100:101], v11 offset:28672
  ds_read_b64_tr_b16 v[102:103], v11 offset:30720
  s_waitcnt lgkmcnt(8)
  v_mfma_f32_16x16x32_bf16 v[84:87], v[108:111], v[32:35], 0
  s_waitcnt lgkmcnt(6)
  v_mfma_f32_16x16x32_bf16 v[72:75], v[88:91], v[36:39], v[72:75]
  s_waitcnt lgkmcnt(4)
  v_mfma_f32_16x16x32_bf16 v[76:79], v[92:95], v[36:39], v[76:79]
  s_waitcnt lgkmcnt(2)
  v_mfma_f32_16x16x32_bf16 v[80:83], v[96:99], v[36:39], v[80:83]
  s_waitcnt lgkmcnt(0)
  v_mfma_f32_16x16x32_bf16 v[84:87], v[100:103], v[36:39], v[84:87]
  v_mov_b32_dpp v56, v60 row_shr:4 row_mask:0xf bank_mask:0x2
  v_mov_b32_dpp v57, v61 row_shr:4 row_mask:0xf bank_mask:0x2
  v_mov_b32_dpp v58, v62 row_shr:4 row_mask:0xf bank_mask:0x2
  v_mov_b32_dpp v59, v63 row_shr:4 row_mask:0xf bank_mask:0x2
  v_mov_b32_dpp v56, v64 row_shr:8 row_mask:0xf bank_mask:0x4
  v_mov_b32_dpp v57, v65 row_shr:8 row_mask:0xf bank_mask:0x4
  v_mov_b32_dpp v58, v66 row_shr:8 row_mask:0xf bank_mask:0x4
  v_mov_b32_dpp v59, v67 row_shr:8 row_mask:0xf bank_mask:0x4
  v_mov_b32_dpp v56, v68 row_shr:12 row_mask:0xf bank_mask:0x8
  v_mov_b32_dpp v57, v69 row_shr:12 row_mask:0xf bank_mask:0x8
  v_mov_b32_dpp v58, v70 row_shr:12 row_mask:0xf bank_mask:0x8
  v_mov_b32_dpp v59, v71 row_shr:12 row_mask:0xf bank_mask:0x8
  v_and_or_b32 v56, v56, v122, s86
  v_and_or_b32 v57, v57, v122, s87
  v_and_or_b32 v58, v58, v122, s88
  v_and_or_b32 v59, v59, v122, s89
  global_store_dwordx4 v4, v[56:59], s[68:69]
  v_mov_b32_dpp v72, v76 row_shr:4 row_mask:0xf bank_mask:0x2
  v_mov_b32_dpp v73, v77 row_shr:4 row_mask:0xf bank_mask:0x2
  v_mov_b32_dpp v74, v78 row_shr:4 row_mask:0xf bank_mask:0x2
  v_mov_b32_dpp v75, v79 row_shr:4 row_mask:0xf bank_mask:0x2
  v_mov_b32_dpp v72, v80 row_shr:8 row_mask:0xf bank_mask:0x4
  v_mov_b32_dpp v73, v81 row_shr:8 row_mask:0xf bank_mask:0x4
  v_mov_b32_dpp v74, v82 row_shr:8 row_mask:0xf bank_mask:0x4
  v_mov_b32_dpp v75, v83 row_shr:8 row_mask:0xf bank_mask:0x4
  v_mov_b32_dpp v72, v84 row_shr:12 row_mask:0xf bank_mask:0x8
  v_mov_b32_dpp v73, v85 row_shr:12 row_mask:0xf bank_mask:0x8
  v_mov_b32_dpp v74, v86 row_shr:12 row_mask:0xf bank_mask:0x8
  v_mov_b32_dpp v75, v87 row_shr:12 row_mask:0xf bank_mask:0x8
  v_and_or_b32 v72, v72, v122, s86
  v_and_or_b32 v73, v73, v122, s87
  v_and_or_b32 v74, v74, v122, s88
  v_and_or_b32 v75, v75, v122, s89
  global_store_dwordx4 v4, v[72:75], s[68:69] offset:128
L_noffn2:
  s_mov_b32 s56, 2000000
  s_waitcnt vmcnt(1)
  s_branch L_idw
L_idl:
  global_load_dwordx4 v[44:47], v12, s[26:27] sc1
  s_waitcnt vmcnt(0)
L_idw:
  v_xor_b32 v44, s60, v44
  v_xor_b32 v45, s61, v45
  v_xor_b32 v46, s62, v46
  v_xor_b32 v47, s63, v47
  v_or3_b32 v48, v44, v45, v46
  v_or_b32 v48, v48, v47
  v_and_b32 v48, 1023, v48
  v_cmpx_ne_u32 vcc, 0, v48
  s_cbranch_vccz L_idg
  s_sub_u32 s56, s56, 1
  s_cbranch_scc0 L_idl
L_idg:
  s_mov_b64 exec, -1
  v_cmp_ne_u32 vcc, s51, v44
  s_cmp_eq_u64 vcc, 0
  s_cselect_b32 s45, 0x400000, 0
  s_cmp_lg_u32 s45, 0
  s_cbranch_scc1 L_loc1
  global_store_dwordx4 v5, v[40:43], s[26:27] sc1
  s_cmp_ge_u32 s30, 28
  s_cbranch_scc1 L_loc1
  global_store_dwordx4 v4, v[56:59], s[26:27] sc1
  global_store_dwordx4 v4, v[72:75], s[26:27] offset:128 sc1
L_loc1:
  v_add_u32 v114, s45, v114
  v_add_u32 v116, s45, v116
  v_add_u32 v118, s45, v118
  v_add_u32 v15, s45, v15
  v_add_u32 v115, 4096, v114
  v_add_u32 v117, 8192, v116
  v_mov_b32 v14, s45
  v_mov_b32 v13, 163072
  ds_write_b32 v13, v14
  s_barrier
  global_load_dwordx4 v[16:19], v114, s[26:27] offset:0 sc1
  global_load_dwordx4 v[20:23], v114, s[26:27] offset:1024 sc1
  global_load_dwordx4 v[24:27], v114, s[26:27] offset:2048 sc1
  global_load_dwordx4 v[28:31], v114, s[26:27] offset:3072 sc1
  global_load_dwordx4 v[32:35], v115, s[26:27] offset:0 sc1
  global_load_dwordx4 v[36:39], v115, s[26:27] offset:1024 sc1
  global_load_dwordx4 v[40:43], v115, s[26:27] offset:2048 sc1
  global_load_dwordx4 v[44:47], v115, s[26:27] offset:3072 sc1
  s_barrier
  s_mov_b32 s56, 2000000
  s_branch L_pw0
L_pl0:
  global_load_dwordx4 v[16:19], v114, s[26:27] offset:0 sc1
  global_load_dwordx4 v[20:23], v114, s[26:27] offset:1024 sc1
  global_load_dwordx4 v[24:27], v114, s[26:27] offset:2048 sc1
  global_load_dwordx4 v[28:31], v114, s[26:27] offset:3072 sc1
  global_load_dwordx4 v[32:35], v115, s[26:27] offset:0 sc1
  global_load_dwordx4 v[36:39], v115, s[26:27] offset:1024 sc1
  global_load_dwordx4 v[40:43], v115, s[26:27] offset:2048 sc1
  global_load_dwordx4 v[44:47], v115, s[26:27] offset:3072 sc1
L_pw0:
  s_waitcnt vmcnt(0)
  v_xor_b32 v16, s86, v16
  v_xor_b32 v17, s87, v17
  v_xor_b32 v18, s88, v18
  v_xor_b32 v19, s89, v19
  v_xor_b32 v20, s86, v20
  v_xor_b32 v21, s87, v21
  v_xor_b32 v22, s88, v22
  v_xor_b32 v23, s89, v23
  v_xor_b32 v24, s86, v24
  v_xor_b32 v25, s87, v25
  v_xor_b32 v26, s88, v26
  v_xor_b32 v27, s89, v27
  v_xor_b32 v28, s86, v28
  v_xor_b32 v29, s87, v29
  v_xor_b32 v30, s88, v30
  v_xor_b32 v31, s89, v31
  v_xor_b32 v32, s86, v32
  v_xor_b32 v33, s87, v33
  v_xor_b32 v34, s88, v34
  v_xor_b32 v35, s89, v35
  v_xor_b32 v36, s86, v36
  v_xor_b32 v37, s87, v37
  v_xor_b32 v38, s88, v38
  v_xor_b32 v39, s89, v39
  v_xor_b32 v40, s86, v40
  v_xor_b32 v41, s87, v41
  v_xor_b32 v42, s88, v42
  v_xor_b32 v43, s89, v43
  v_xor_b32 v44, s86, v44
  v_xor_b32 v45, s87, v45
  v_xor_b32 v46, s88, v46
  v_xor_b32 v47, s89, v47
  v_or3_b32 v121, v16, v17, v18
  v_or3_b32 v121, v121, v19, v20
  v_or3_b32 v121, v121, v21, v22
  v_or3_b32 v121, v121, v23, v24
  v_or3_b32 v121, v121, v25, v26
  v_or3_b32 v121, v121, v27, v28
  v_or3_b32 v121, v121, v29, v30
  v_or3_b32 v121, v121, v31, v32
  v_or3_b32 v121, v121, v33, v34
  v_or3_b32 v121, v121, v35, v36
  v_or3_b32 v121, v121, v37, v38
  v_or3_b32 v121, v121, v39, v40
  v_or3_b32 v121, v121, v41, v42
  v_or3_b32 v121, v121, v43, v44
  v_or3_b32 v121, v121, v45, v46
  v_or_b32 v121, v121, v47
  v_and_b32 v121, 63, v121
  v_cmpx_ne_u32 vcc, 0, v121
  s_cbranch_vccz L_pg0
  s_sub_u32 s56, s56, 1
  s_cbranch_scc0 L_pl0
L_pg0:
  s_mov_b64 exec, -1
  s_cmp_ge_u32 s30, 28
  s_cbranch_scc1 L_noffn3
  global_load_dwordx4 v[48:51], v116, s[26:27] sc1
  global_load_dwordx4 v[52:55], v117, s[26:27] sc1
L_noffn3:
  v_pk_add_f32 v[16:17], v[16:17], v[24:25]
  v_pk_add_f32 v[32:33], v[32:33], v[40:41]
  v_pk_add_f32 v[18:19], v[18:19], v[26:27]
  v_pk_add_f32 v[34:35], v[34:35], v[42:43]
  v_pk_add_f32 v[20:21], v[20:21], v[28:29]
  v_pk_add_f32 v[36:37], v[36:37], v[44:45]
  v_pk_add_f32 v[22:23], v[22:23], v[30:31]
  v_pk_add_f32 v[38:39], v[38:39], v[46:47]
  v_pk_add_f32 v[16:17], v[16:17], v[32:33]
  v_pk_add_f32 v[18:19], v[18:19], v[34:35]
  v_pk_add_f32 v[20:21], v[20:21], v[36:37]
  v_pk_add_f32 v[22:23], v[22:23], v[38:39]
  v_cvt_pk_bf16_f32 v16, v16, v17
  v_cvt_pk_bf16_f32 v17, v18, v19
  v_cvt_pk_bf16_f32 v18, v20, v21
  v_cvt_pk_bf16_f32 v19, v22, v23
  ds_write_b64 v124, v[16:17]
  ds_write_b64 v124, v[18:19] offset:512
  s_waitcnt lgkmcnt(0)
  s_barrier
  s_cmp_ge_u32 s30, 28
  s_cbranch_scc1 L_noffn4
  s_mov_b32 s56, 2000000
  s_branch L_pw1
L_pl1:
  global_load_dwordx4 v[48:51], v116, s[26:27] sc1
  global_load_dwordx4 v[52:55], v117, s[26:27] sc1
L_pw1:
  s_waitcnt vmcnt(0)
  v_xor_b32 v48, s86, v48
  v_xor_b32 v49, s87, v49
  v_xor_b32 v50, s88, v50
  v_xor_b32 v51, s89, v51
  v_xor_b32 v52, s86, v52
  v_xor_b32 v53, s87, v53
  v_xor_b32 v54, s88, v54
  v_xor_b32 v55, s89, v55
  v_or3_b32 v121, v48, v49, v50
  v_or3_b32 v121, v121, v51, v52
  v_or3_b32 v121, v121, v53, v54
  v_or_b32 v121, v121, v55
  v_and_b32 v121, 63, v121
  v_cmpx_ne_u32 vcc, 0, v121
  s_cbranch_vccz L_pg1
  s_sub_u32 s56, s56, 1
  s_cbranch_scc0 L_pl1
L_pg1:
  s_mov_b64 exec, -1
  v_pk_add_f32 v[48:49], v[48:49], v[52:53]
  v_pk_add_f32 v[50:51], v[50:51], v[54:55]
  v_mov_b32 v52, v48
  v_mov_b32 v53, v49
  v_mov_b32 v54, v50
  v_mov_b32 v55, v51
  s_nop 0
  v_permlane16_swap_b32 v48, v52
  v_permlane16_swap_b32 v49, v53
  v_permlane16_swap_b32 v50, v54
  v_permlane16_swap_b32 v51, v55
  s_nop 0
  v_add_f32 v48, v48, v52
  v_add_f32 v49, v49, v53
  v_add_f32 v50, v50, v54
  v_add_f32 v51, v51, v55
  v_mov_b32 v52, v48
  v_mov_b32 v53, v49
  v_mov_b32 v54, v50
  v_mov_b32 v55, v51
  s_nop 0
  v_permlane32_swap_b32 v48, v52
  v_permlane32_swap_b32 v49, v53
  v_permlane32_swap_b32 v50, v54
  v_permlane32_swap_b32 v51, v55
  s_nop 0
  v_add_f32 v48, v48, v52
  v_add_f32 v49, v49, v53
  v_add_f32 v50, v50, v54
  v_add_f32 v51, v51, v55
  v_cvt_pk_bf16_f32 v52, v48, v49
  v_cvt_pk_bf16_f32 v53, v50, v51
  v_lshlrev_b32 v48, 16, v52
  v_and_b32 v49, s52, v52
  v_lshlrev_b32 v50, 16, v53
  v_and_b32 v51, s52, v53
  s_nop 0
  v_mul_f32_dpp v52, v48, v48 row_ror:8 row_mask:0xf bank_mask:0xf
  v_mul_f32_dpp v53, v49, v49 row_ror:8 row_mask:0xf bank_mask:0xf
  v_mul_f32_dpp v54, v50, v50 row_ror:8 row_mask:0xf bank_mask:0xf
  v_mul_f32_dpp v55, v51, v51 row_ror:8 row_mask:0xf bank_mask:0xf
  v_cvt_pk_bf16_f32 v48, v52, v53
  v_cvt_pk_bf16_f32 v49, v54, v55
  v_lshlrev_b32 v52, 16, v48
  v_and_b32 v53, s52, v48
  v_lshlrev_b32 v54, 16, v49
  v_and_b32 v55, s52, v49
  v_and_or_b32 v52, v52, v123, s60
  v_and_or_b32 v53, v53, v123, s61
  v_and_or_b32 v54, v54, v123, s62
  v_and_or_b32 v55, v55, v123, s63
  s_mov_b64 exec, 0xff
  s_cmp_lg_u32 s45, 0
  s_cbranch_scc1 L_ms0
  global_store_dwordx4 v119, v[52:55], s[26:27] sc1
  s_branch L_me0
L_ms0:
  global_store_dwordx4 v119, v[52:55], s[68:69]
L_me0:
  s_mov_b64 exec, -1
L_noffn4:
  s_barrier
  s_barrier
  ds_read_b128 v[16:19], v126
  ds_read_b128 v[20:23], v126 offset:16
  ds_read_b128 v[24:27], v126 offset:128
  ds_read_b128 v[28:31], v126 offset:144
  s_waitcnt lgkmcnt(0)
  v_max3_f32 v16, v16, v17, v18
  v_max3_f32 v20, v20, v21, v22
  v_max3_f32 v16, v16, v19, v23
  v_max_f32 v16, v16, v20
  v_pk_add_f32 v[24:25], v[24:25], v[28:29]
  v_pk_add_f32 v[26:27], v[26:27], v[30:31]
  v_pk_add_f32 v[24:25], v[24:25], v[26:27]
  v_add_f32 v17, v24, v25
  v_and_or_b32 v16, v16, v123, s60
  v_and_or_b32 v17, v17, v123, s61
  v_and_or_b32 v18, v18, v123, s62
  v_and_or_b32 v19, v19, v123, s63
  s_mov_b64 exec, 0xf
  s_cmp_lg_u32 s45, 0
  s_cbranch_scc1 L_ms1
  global_store_dwordx4 v120, v[16:19], s[26:27] sc1
  s_branch L_me1
L_ms1:
  global_store_dwordx4 v120, v[16:19], s[68:69]
L_me1:
  s_mov_b64 exec, -1
  v_lshlrev_b32 v7, 16, v7
  s_mov_b32 s53, 0
  s_mov_b32 s56, 2000000
  s_waitcnt vmcnt(0)
L_sl:
  global_load_dwordx4 v[20:23], v15, s[26:27] sc1
  global_load_dwordx4 v[24:27], v15, s[26:27] offset:512 sc1
  global_load_dwordx4 v[48:51], v118, s[26:27] sc1
  s_cmp_ge_u32 s53, 2
  s_cbranch_scc1 L_sw
  s_add_u32 s53, s53, 1
  s_barrier
L_sw:
  s_waitcnt vmcnt(0)
  v_xor_b32 v20, s60, v20
  v_xor_b32 v21, s61, v21
  v_xor_b32 v22, s62, v22
  v_xor_b32 v23, s63, v23
  v_xor_b32 v24, s60, v24
  v_xor_b32 v25, s61, v25
  v_xor_b32 v26, s62, v26
  v_xor_b32 v27, s63, v27
  v_xor_b32 v48, s60, v48
  v_xor_b32 v49, s61, v49
  v_xor_b32 v50, s62, v50
  v_xor_b32 v51, s63, v51
  v_or3_b32 v28, v20, v21, v22
  v_or3_b32 v28, v28, v23, v24
  v_or3_b32 v28, v28, v25, v26
  v_or3_b32 v28, v28, v27, v48
  v_or3_b32 v28, v28, v49, v50
  v_or_b32 v28, v28, v51
  v_and_b32 v28, 1023, v28
  v_cmpx_ne_u32 vcc, 0, v28
  s_cbranch_vccz L_sg
  s_sub_u32 s56, s56, 1
  s_cbranch_scc0 L_sl
L_sg:
  s_mov_b64 exec, -1
  v_cvt_pk_bf16_f32 v48, v48, v49
  v_cvt_pk_bf16_f32 v49, v50, v51
  ds_write_b64 v125, v[48:49]
  v_max_f32 v28, v20, v24
  v_mov_b32 v29, v28
  s_nop 1
  v_permlane16_swap_b32 v28, v29
  s_nop 0
  v_max_f32 v28, v28, v29
  v_mov_b32 v29, v28
  s_nop 1
  v_permlane32_swap_b32 v28, v29
  s_nop 0
  v_max_f32 v28, v28, v29
  v_sub_f32 v20, v20, v28
  v_sub_f32 v24, v24, v28
  v_mul_f32 v20, s50, v20
  v_mul_f32 v24, s50, v24
  v_exp_f32 v20, v20
  v_exp_f32 v24, v24
  s_nop 0
  v_mul_f32 v28, v20, v21
  v_fmac_f32 v28, v24, v25
  v_mov_b32 v29, v28
  s_nop 1
  v_permlane16_swap_b32 v28, v29
  s_nop 0
  v_add_f32 v28, v28, v29
  v_mov_b32 v29, v28
  s_nop 1
  v_permlane32_swap_b32 v28, v29
  s_nop 0
  v_add_f32 v28, v28, v29
  v_rcp_f32 v28, v28
  s_nop 0
  v_mul_f32 v20, v20, v28
  v_mul_f32 v21, v24, v28
  ds_write_b64 v124, v[20:21] offset:2816
  s_waitcnt lgkmcnt(0)
  s_cmp_ge_u32 s53, 2
  s_cbranch_scc1 L_s2
  s_barrier
L_s2:
  s_barrier
  s_barrier
  s_mov_b32 s56, 2000000
L_pl2:
  global_load_dwordx4 v[16:19], v127, s[26:27] sc1
L_pw2:
  s_waitcnt vmcnt(0)
  v_xor_b32 v16, s60, v16
  v_xor_b32 v17, s61, v17
  v_xor_b32 v18, s62, v18
  v_xor_b32 v19, s63, v19
  v_or3_b32 v20, v16, v17, v18
  v_or_b32 v20, v20, v19
  v_and_b32 v20, 1023, v20
  v_cmpx_ne_u32 vcc, 0, v20
  s_cbranch_vccz L_pg2
  s_sub_u32 s56, s56, 1
  s_cbranch_scc0 L_pl2
L_pg2:
  s_mov_b64 exec, -1
  s_nop 1
  v_permlane32_swap_b32 v16, v18
  v_permlane32_swap_b32 v17, v19
  s_nop 0
  v_add_f32 v16, v16, v18
  v_add_f32 v17, v17, v19
  s_nop 1
  v_permlane16_swap_b32 v16, v17
  s_nop 0
  v_add_f32 v16, v16, v17
  s_nop 1
  v_add_f32_dpp v16, v16, v16 quad_perm:[2,3,0,1] row_mask:0xf bank_mask:0xf
  s_nop 1
  v_add_f32_dpp v16, v16, v16 row_ror:4 row_mask:0xf bank_mask:0xf
  s_nop 1
  v_add_f32_dpp v16, v16, v16 row_ror:8 row_mask:0xf bank_mask:0xf
  v_add_f32 v16, v16, v7
  v_cvt_pk_bf16_f32 v16, v16, v16
  s_mov_b32 exec_lo, 0x00030003
  s_mov_b32 exec_hi, 0x00030003
  global_store_short v113, v16, s[22:23]
  s_cmp_lg_u32 s2, 0
  s_cbranch_scc1 L_cend
  s_mov_b64 exec, 1
  v_mov_b32 v8, 0
  v_mov_b32 v10, s64
  v_mov_b32 v11, s65
  global_store_dwordx2 v8, v[10:11], s[26:27]
L_cend:
  s_endpgm
L_load2:
  s_lshl2_add_u32 s33, s29, s31
  v_lshrrev_b32 v4, 5, v0
  v_bfe_u32 v5, v0, 3, 2
  v_lshl_add_u32 v4, v4, 3, v5
  v_bfe_u32 v5, v0, 1, 2
  v_xor_b32 v5, v5, v1
  v_lshlrev_b32 v7, 4, v6
  v_lshl_add_u32 v5, v5, 5, v7
  s_lshl_b32 s35, s32, 7
  v_lshl_add_u32 v8, v4, 10, v5
  v_add_u32 v9, 15360, v8
  v_add_u32 v10, 2048, v8
  v_add_u32 v11, 17408, v8
  s_xor_b32 s35, s35, 512
  s_lshl_b32 s38, s33, 17
  s_add_u32 s38, s38, s35
  s_lshl_b32 s39, s30, 16
  s_add_u32 s39, s39, s35
  s_add_u32 m0, s37, 131072
  s_add_u32 s40, s12, s38
  s_addc_u32 s41, s13, 0
  global_load_lds_dwordx4 v8, s[40:41] offset:0 nt
  global_load_lds_dwordx4 v9, s[40:41] offset:1024 nt
  global_load_lds_dwordx4 v10, s[40:41] offset:2048 nt
  global_load_lds_dwordx4 v11, s[40:41] offset:3072 nt
  s_addk_i32 m0, 4096
  s_add_u32 s40, s40, 32768
  s_addc_u32 s41, s41, 0
  global_load_lds_dwordx4 v8, s[40:41] offset:0 nt
  global_load_lds_dwordx4 v9, s[40:41] offset:1024 nt
  global_load_lds_dwordx4 v10, s[40:41] offset:2048 nt
  global_load_lds_dwordx4 v11, s[40:41] offset:3072 nt
  s_addk_i32 m0, 4096
  s_add_u32 s40, s40, 32768
  s_addc_u32 s41, s41, 0
  global_load_lds_dwordx4 v8, s[40:41] offset:0 nt
  global_load_lds_dwordx4 v9, s[40:41] offset:1024 nt
  global_load_lds_dwordx4 v10, s[40:41] offset:2048 nt
  global_load_lds_dwordx4 v11, s[40:41] offset:3072 nt
  s_addk_i32 m0, 4096
  s_add_u32 s40, s40, 32768
  s_addc_u32 s41, s41, 0
  global_load_lds_dwordx4 v8, s[40:41] offset:0 nt
  global_load_lds_dwordx4 v9, s[40:41] offset:1024 nt
  global_load_lds_dwordx4 v10, s[40:41] offset:2048 nt
  global_load_lds_dwordx4 v11, s[40:41] offset:3072 nt
  s_cmp_ge_u32 s30, 28
  s_cbranch_scc1 L_nwd
  s_addk_i32 m0, 4096
  s_add_u32 s40, s20, s39
  s_addc_u32 s41, s21, 0
  global_load_lds_dwordx4 v8, s[40:41] offset:0 nt
  global_load_lds_dwordx4 v9, s[40:41] offset:1024 nt
  global_load_lds_dwordx4 v10, s[40:41] offset:2048 nt
  global_load_lds_dwordx4 v11, s[40:41] offset:3072 nt
  s_addk_i32 m0, 4096
  s_add_u32 s40, s40, 32768
  s_addc_u32 s41, s41, 0
  global_load_lds_dwordx4 v8, s[40:41] offset:0 nt
  global_load_lds_dwordx4 v9, s[40:41] offset:1024 nt
  global_load_lds_dwordx4 v10, s[40:41] offset:2048 nt
  global_load_lds_dwordx4 v11, s[40:41] offset:3072 nt
  s_waitcnt vmcnt(24)
  s_branch L_lw1
L_nwd:
  s_waitcnt vmcnt(16)
L_lw1:
  s_barrier
  s_barrier
  s_waitcnt vmcnt(0)
  s_barrier
  s_endpgm
L_comp:
  s_sub_u32 s34, s28, 2
  v_and_b32 v2, 15, v0
  v_lshrrev_b32 v4, 1, v1
  v_and_b32 v5, 7, v0
  v_xor_b32 v4, v4, v5
  v_lshlrev_b32 v4, 5, v4
  v_lshl_add_u32 v4, v2, 8, v4
  v_and_b32 v5, 1, v1
  v_lshl_add_u32 v4, v5, 4, v4
  s_lshl_b32 s36, s34, 12
  v_add_u32 v4, s36, v4
  v_xor_b32 v5, 64, v4
  v_xor_b32 v6, 128, v4
  v_xor_b32 v7, 192, v4
  v_add_u32 v124, 0x10000, v4
  v_add_u32 v125, 0x10000, v5
  v_add_u32 v126, 0x10000, v6
  v_add_u32 v127, 0x10000, v7
  s_waitcnt lgkmcnt(0)
  s_load_dwordx2 s[64:65], s[26:27], 0
  v_lshlrev_b32 v8, 8, v3
  v_lshl_add_u32 v8, v1, 4, v8
  v_add_u32 v8, 159744, v8
  v_lshlrev_b32 v10, 5, v3
  v_add_u32 v10, 162304, v10
  s_lshl_b32 s46, s34, 2
  v_add_u32 v11, s46, v10
  v_lshlrev_b32 v12, 6, v1
  v_lshl_add_u32 v12, v3, 4, v12
  v_add_u32 v12, 155648, v12
  s_lshr_b32 s46, s34, 1
  s_lshl_b32 s46, s46, 8
  s_and_b32 s47, s34, 1
  s_lshl3_add_u32 s46, s47, s46
  v_add_u32 v13, s46, v12
  v_lshrrev_b32 v117, 2, v0
  v_and_b32 v15, 7, v117
  v_xor_b32 v15, s34, v15
  v_lshlrev_b32 v14, 8, v117
  v_lshl_add_u32 v14, v15, 5, v14
  v_lshl_add_u32 v14, v3, 3, v14
  v_add_u32 v15, 0x10000, v14
  s_lshl3_add_u32 s46, s33, s32
  s_lshl3_add_u32 s46, s46, s34
  s_lshl_b32 s46, s46, 8
  s_add_u32 s46, s46, 1048576
  v_lshlrev_b32 v119, 6, v3
  v_lshl_add_u32 v119, v1, 4, v119
  v_add_u32 v112, s46, v119
  v_mov_b32 v9, 163072
  s_lshl_b32 s46, s29, 16
  s_lshl_b32 s47, s34, 8
  s_add_u32 s46, s46, s47
  s_lshl_b32 s47, s31, 6
  s_add_u32 s46, s46, s47
  s_add_u32 s46, s46, 1048576
  v_bfe_u32 v115, v0, 2, 2
  v_lshlrev_b32 v113, 14, v115
  v_lshl_add_u32 v113, v1, 11, v113
  v_lshl_add_u32 v113, v3, 4, v113
  v_add_u32 v113, s46, v113
  v_lshlrev_b32 v114, 3, v0
  v_add_u32 v114, 162560, v114
  v_lshlrev_b32 v115, 8, v115
  s_lshl_b32 s46, s34, 5
  s_add_u32 s46, s46, 161280
  v_lshl_add_u32 v115, v3, 3, v115
  v_lshl_add_u32 v115, v1, 1, v115
  v_add_u32 v115, s46, v115
  s_and_b32 s46, s34, 3
  v_bfe_u32 v116, v0, 3, 2
  v_xor_b32 v116, s46, v116
  v_lshlrev_b32 v116, 5, v116
  v_lshl_add_u32 v116, v117, 7, v116
  v_lshl_add_u32 v116, v3, 3, v116
  v_add_u32 v116, 131072, v116
  v_lshlrev_b32 v117, 7, v3
  v_lshl_add_u32 v117, v1, 4, v117
  v_add_u32 v117, 160768, v117
  s_xor_b32 s47, s32, 4
  s_lshl_b32 s47, s47, 5
  s_add_u32 s47, s47, s33
  s_lshl2_add_u32 s46, s47, s46
  s_lshl_b32 s46, s46, 8
  s_add_u32 s46, s46, 1572864
  v_add_u32 v118, s46, v119
  s_mov_b32 s50, 0x3fb8aa3b
  v_mov_b32 v120, 0x3db504f3
  v_mov_b32 v121, 0x3db504f3
  s_mov_b32 s52, 0xffff0000
  s_mov_b32 s54, 0x000f000f
  s_mov_b32 s55, 0x000f000f
  s_waitcnt lgkmcnt(0)
  s_add_u32 s64, s64, 0x7f4a7c15
  s_addc_u32 s65, s65, 0x9e3779b9
  s_and_b32 s60, s64, 1023
  s_bfe_u32 s61, s64, 0xa000a
  s_bfe_u32 s62, s64, 0xa0014
  s_and_b32 s63, s65, 1023
  v_mov_b32 v123, 0xfffffc00
  s_add_u32 s68, s26, 0x400000
  s_addc_u32 s69, s27, 0
  s_barrier
  ds_read_b128 v[16:19], v4 offset:0
  ds_read_b128 v[20:23], v5 offset:0
  ds_read_b128 v[24:27], v6 offset:0
  ds_read_b128 v[28:31], v7 offset:0
  ds_read_b128 v[32:35], v4 offset:32768
  ds_read_b128 v[36:39], v5 offset:32768
  ds_read_b128 v[40:43], v6 offset:32768
  ds_read_b128 v[44:47], v7 offset:32768
  s_waitcnt lgkmcnt(0)
  s_barrier
  s_barrier
  ds_read_b128 v[80:83], v8 offset:0
  ds_read_b128 v[84:87], v8 offset:64
  ds_read_b128 v[88:91], v8 offset:128
  ds_read_b128 v[92:95], v8 offset:192
  ds_read_b128 v[48:51], v124 offset:0
  ds_read_b128 v[52:55], v125 offset:0
  ds_read_b128 v[56:59], v126 offset:0
  ds_read_b128 v[60:63], v127 offset:0
  ds_read_b128 v[64:67], v124 offset:32768
  ds_read_b128 v[68:71], v125 offset:32768
  ds_read_b128 v[72:75], v126 offset:32768
  ds_read_b128 v[76:79], v127 offset:32768
  s_waitcnt lgkmcnt(8)
  v_mfma_f32_16x16x32_bf16 v[96:99], v[16:19], v[80:83], 0
  v_mfma_f32_16x16x32_bf16 v[100:103], v[32:35], v[80:83], 0
  v_mfma_f32_16x16x32_bf16 v[96:99], v[20:23], v[84:87], v[96:99]
  v_mfma_f32_16x16x32_bf16 v[100:103], v[36:39], v[84:87], v[100:103]
  v_mfma_f32_16x16x32_bf16 v[96:99], v[24:27], v[88:91], v[96:99]
  v_mfma_f32_16x16x32_bf16 v[100:103], v[40:43], v[88:91], v[100:103]
  v_mfma_f32_16x16x32_bf16 v[96:99], v[28:31], v[92:95], v[96:99]
  v_mfma_f32_16x16x32_bf16 v[100:103], v[44:47], v[92:95], v[100:103]
  s_waitcnt lgkmcnt(0)
  v_mfma_f32_16x16x32_bf16 v[104:107], v[48:51], v[80:83], 0
  v_mfma_f32_16x16x32_bf16 v[108:111], v[64:67], v[80:83], 0
  v_mfma_f32_16x16x32_bf16 v[104:107], v[52:55], v[84:87], v[104:107]
  v_mfma_f32_16x16x32_bf16 v[108:111], v[68:71], v[84:87], v[108:111]
  v_mfma_f32_16x16x32_bf16 v[104:107], v[56:59], v[88:91], v[104:107]
  v_mfma_f32_16x16x32_bf16 v[108:111], v[72:75], v[88:91], v[108:111]
  v_mfma_f32_16x16x32_bf16 v[104:107], v[60:63], v[92:95], v[104:107]
  v_mfma_f32_16x16x32_bf16 v[108:111], v[76:79], v[92:95], v[108:111]
  s_nop 3
  v_cvt_pk_bf16_f32 v16, v96, v97
  v_cvt_pk_bf16_f32 v17, v98, v99
  v_cvt_pk_bf16_f32 v18, v100, v101
  v_cvt_pk_bf16_f32 v19, v102, v103
  v_cvt_pk_bf16_f32 v20, v104, v105
  v_cvt_pk_bf16_f32 v21, v106, v107
  v_cvt_pk_bf16_f32 v22, v108, v109
  v_cvt_pk_bf16_f32 v23, v110, v111
  v_lshlrev_b32 v96, 16, v16
  v_and_b32 v97, s52, v16
  v_lshlrev_b32 v98, 16, v17
  v_and_b32 v99, s52, v17
  v_lshlrev_b32 v100, 16, v18
  v_and_b32 v101, s52, v18
  v_lshlrev_b32 v102, 16, v19
  v_and_b32 v103, s52, v19
  v_lshlrev_b32 v104, 16, v20
  v_and_b32 v105, s52, v20
  v_lshlrev_b32 v106, 16, v21
  v_and_b32 v107, s52, v21
  v_lshlrev_b32 v108, 16, v22
  v_and_b32 v109, s52, v22
  v_lshlrev_b32 v110, 16, v23
  v_and_b32 v111, s52, v23
  v_pk_mul_f32 v[96:97], v[96:97], v[120:121]
  v_pk_mul_f32 v[98:99], v[98:99], v[120:121]
  v_pk_mul_f32 v[100:101], v[100:101], v[120:121]
  v_pk_mul_f32 v[102:103], v[102:103], v[120:121]
  v_pk_mul_f32 v[104:105], v[104:105], v[120:121]
  v_pk_mul_f32 v[106:107], v[106:107], v[120:121]
  v_pk_mul_f32 v[108:109], v[108:109], v[120:121]
  v_pk_mul_f32 v[110:111], v[110:111], v[120:121]
  v_cvt_pk_bf16_f32 v16, v96, v97
  v_cvt_pk_bf16_f32 v17, v98, v99
  v_cvt_pk_bf16_f32 v18, v100, v101
  v_cvt_pk_bf16_f32 v19, v102, v103
  v_cvt_pk_bf16_f32 v20, v104, v105
  v_cvt_pk_bf16_f32 v21, v106, v107
  v_cvt_pk_bf16_f32 v22, v108, v109
  v_cvt_pk_bf16_f32 v23, v110, v111
  v_lshlrev_b32 v96, 16, v16
  v_and_b32 v97, s52, v16
  v_lshlrev_b32 v98, 16, v17
  v_and_b32 v99, s52, v17
  v_lshlrev_b32 v100, 16, v18
  v_and_b32 v101, s52, v18
  v_lshlrev_b32 v102, 16, v19
  v_and_b32 v103, s52, v19
  v_lshlrev_b32 v104, 16, v20
  v_and_b32 v105, s52, v20
  v_lshlrev_b32 v106, 16, v21
  v_and_b32 v107, s52, v21
  v_lshlrev_b32 v108, 16, v22
  v_and_b32 v109, s52, v22
  v_lshlrev_b32 v110, 16, v23
  v_and_b32 v111, s52, v23
  v_max3_f32 v24, v96, v97, v98
  v_max3_f32 v25, v99, v100, v101
  v_max3_f32 v26, v102, v103, v104
  v_max3_f32 v27, v105, v106, v107
  v_max3_f32 v24, v24, v108, v109
  v_max3_f32 v25, v25, v110, v111
  v_max3_f32 v24, v24, v25, v26
  v_max_f32 v24, v24, v27
  v_mov_b32 v25, v24
  s_nop 1
  v_permlane16_swap_b32 v24, v25
  s_nop 0
  v_max_f32 v24, v24, v25
  v_mov_b32 v25, v24
  s_nop 1
  v_permlane32_swap_b32 v24, v25
  s_nop 0
  v_max_f32 v24, v24, v25
  s_mov_b64 exec, 0xf
  ds_write_b32 v11, v24
  s_mov_b64 exec, -1
  s_waitcnt lgkmcnt(0)
  s_barrier
  ds_read_b128 v[24:27], v10
  ds_read_b128 v[28:31], v10 offset:16
  ds_read_b32 v9, v9
  s_waitcnt lgkmcnt(0)
  v_readfirstlane_b32 s45, v9
  v_add_u32 v113, v113, v9
  v_add_u32 v122, 8192, v113
  v_max3_f32 v24, v24, v25, v26
  v_max3_f32 v28, v28, v29, v30
  v_max3_f32 v24, v24, v27, v31
  v_max_f32 v24, v24, v28
  v_sub_f32 v96, v96, v24
  v_sub_f32 v97, v97, v24
  v_sub_f32 v98, v98, v24
  v_sub_f32 v99, v99, v24
  v_sub_f32 v100, v100, v24
  v_sub_f32 v101, v101, v24
  v_sub_f32 v102, v102, v24
  v_sub_f32 v103, v103, v24
  v_sub_f32 v104, v104, v24
  v_sub_f32 v105, v105, v24
  v_sub_f32 v106, v106, v24
  v_sub_f32 v107, v107, v24
  v_sub_f32 v108, v108, v24
  v_sub_f32 v109, v109, v24
  v_sub_f32 v110, v110, v24
  v_sub_f32 v111, v111, v24
  v_mul_f32 v96, s50, v96
  v_mul_f32 v97, s50, v97
  v_mul_f32 v98, s50, v98
  v_mul_f32 v99, s50, v99
  v_mul_f32 v100, s50, v100
  v_mul_f32 v101, s50, v101
  v_mul_f32 v102, s50, v102
  v_mul_f32 v103, s50, v103
  v_mul_f32 v104, s50, v104
  v_mul_f32 v105, s50, v105
  v_mul_f32 v106, s50, v106
  v_mul_f32 v107, s50, v107
  v_mul_f32 v108, s50, v108
  v_mul_f32 v109, s50, v109
  v_mul_f32 v110, s50, v110
  v_mul_f32 v111, s50, v111
  v_exp_f32 v96, v96
  v_exp_f32 v97, v97
  v_exp_f32 v98, v98
  v_exp_f32 v99, v99
  v_exp_f32 v100, v100
  v_exp_f32 v101, v101
  v_exp_f32 v102, v102
  v_exp_f32 v103, v103
  v_exp_f32 v104, v104
  v_exp_f32 v105, v105
  v_exp_f32 v106, v106
  v_exp_f32 v107, v107
  v_exp_f32 v108, v108
  v_exp_f32 v109, v109
  v_exp_f32 v110, v110
  v_exp_f32 v111, v111
  s_nop 0
  v_cvt_pk_bf16_f32 v16, v96, v97
  v_cvt_pk_bf16_f32 v17, v98, v99
  v_cvt_pk_bf16_f32 v18, v100, v101
  v_cvt_pk_bf16_f32 v19, v102, v103
  v_cvt_pk_bf16_f32 v20, v104, v105
  v_cvt_pk_bf16_f32 v21, v106, v107
  v_cvt_pk_bf16_f32 v22, v108, v109
  v_cvt_pk_bf16_f32 v23, v110, v111
  v_pk_add_f32 v[96:97], v[96:97], v[104:105]
  v_pk_add_f32 v[98:99], v[98:99], v[106:107]
  v_pk_add_f32 v[100:101], v[100:101], v[108:109]
  v_pk_add_f32 v[102:103], v[102:103], v[110:111]
  v_pk_add_f32 v[96:97], v[96:97], v[100:101]
  v_pk_add_f32 v[98:99], v[98:99], v[102:103]
  v_pk_add_f32 v[96:97], v[96:97], v[98:99]
  v_add_f32 v24, v96, v97
  s_mov_b64 exec, s[54:55]
  ds_write_b64 v13, v[16:17] offset:0
  ds_write_b64 v13, v[18:19] offset:1024
  ds_write_b64 v13, v[20:21] offset:2048
  ds_write_b64 v13, v[22:23] offset:3072
  s_mov_b64 exec, -1
  v_mov_b32 v25, v24
  s_nop 1
  v_permlane16_swap_b32 v24, v25
  s_nop 0
  v_add_f32 v24, v24, v25
  v_mov_b32 v25, v24
  s_nop 1
  v_permlane32_swap_b32 v24, v25
  s_nop 0
  v_add_f32 v24, v24, v25
  s_mov_b64 exec, 0xf
  ds_write_b32 v11, v24 offset:128
  s_mov_b64 exec, -1
  s_waitcnt lgkmcnt(0)
  s_barrier
  ds_read_b128 v[16:19], v12 offset:0
  ds_read_b128 v[20:23], v12 offset:256
  ds_read_b128 v[24:27], v12 offset:512
  ds_read_b128 v[28:31], v12 offset:768
  ds_read_b128 v[32:35], v12 offset:1024
  ds_read_b128 v[36:39], v12 offset:1280
  ds_read_b128 v[40:43], v12 offset:1536
  ds_read_b128 v[44:47], v12 offset:1792
  s_waitcnt lgkmcnt(4)
  ds_read_b128 v[48:51], v12 offset:2048
  ds_read_b128 v[52:55], v12 offset:2304
  ds_read_b128 v[56:59], v12 offset:2560
  ds_read_b128 v[60:63], v12 offset:2816
  ds_read_b128 v[64:67], v12 offset:3072
  ds_read_b128 v[68:71], v12 offset:3328
  ds_read_b128 v[72:75], v12 offset:3584
  ds_read_b128 v[76:79], v12 offset:3840
  s_waitcnt lgkmcnt(0)
  ds_read_b64_tr_b16 v[80:81], v14 offset:0
  ds_read_b64_tr_b16 v[82:83], v14 offset:4096
  ds_read_b64_tr_b16 v[84:85], v14 offset:8192
  ds_read_b64_tr_b16 v[86:87], v14 offset:12288
  ds_read_b64_tr_b16 v[88:89], v14 offset:16384
  ds_read_b64_tr_b16 v[90:91], v14 offset:20480
  ds_read_b64_tr_b16 v[92:93], v14 offset:24576
  ds_read_b64_tr_b16 v[94:95], v14 offset:28672
  ds_read_b64_tr_b16 v[100:101], v14 offset:32768
  ds_read_b64_tr_b16 v[102:103], v14 offset:36864
  s_waitcnt lgkmcnt(8)
  v_mfma_f32_16x16x32_bf16 v[96:99], v[80:83], v[16:19], 0
  ds_read_b64_tr_b16 v[104:105], v14 offset:40960
  ds_read_b64_tr_b16 v[106:107], v14 offset:45056
  s_waitcnt lgkmcnt(8)
  v_mfma_f32_16x16x32_bf16 v[96:99], v[84:87], v[20:23], v[96:99]
  ds_read_b64_tr_b16 v[80:81], v14 offset:49152
  ds_read_b64_tr_b16 v[82:83], v14 offset:53248
  s_waitcnt lgkmcnt(8)
  v_mfma_f32_16x16x32_bf16 v[96:99], v[88:91], v[24:27], v[96:99]
  ds_read_b64_tr_b16 v[84:85], v14 offset:57344
  ds_read_b64_tr_b16 v[86:87], v14 offset:61440
  s_waitcnt lgkmcnt(8)
  v_mfma_f32_16x16x32_bf16 v[96:99], v[92:95], v[28:31], v[96:99]
  s_waitcnt lgkmcnt(6)
  v_mfma_f32_16x16x32_bf16 v[96:99], v[100:103], v[32:35], v[96:99]
  s_waitcnt lgkmcnt(4)
  v_mfma_f32_16x16x32_bf16 v[96:99], v[104:107], v[36:39], v[96:99]
  s_waitcnt lgkmcnt(2)
  v_mfma_f32_16x16x32_bf16 v[96:99], v[80:83], v[40:43], v[96:99]
  s_waitcnt lgkmcnt(0)
  v_mfma_f32_16x16x32_bf16 v[96:99], v[84:87], v[44:47], v[96:99]
  s_barrier
  ds_read_b64_tr_b16 v[88:89], v15 offset:0
  ds_read_b64_tr_b16 v[90:91], v15 offset:4096
  ds_read_b64_tr_b16 v[92:93], v15 offset:8192
  ds_read_b64_tr_b16 v[94:95], v15 offset:12288
  ds_read_b64_tr_b16 v[100:101], v15 offset:16384
  ds_read_b64_tr_b16 v[102:103], v15 offset:20480
  ds_read_b64_tr_b16 v[104:105], v15 offset:24576
  ds_read_b64_tr_b16 v[106:107], v15 offset:28672
  ds_read_b64_tr_b16 v[80:81], v15 offset:32768
  ds_read_b64_tr_b16 v[82:83], v15 offset:36864
  s_waitcnt lgkmcnt(8)
  v_mfma_f32_16x16x32_bf16 v[96:99], v[88:91], v[48:51], v[96:99]
  s_waitcnt lgkmcnt(6)
  v_mfma_f32_16x16x32_bf16 v[96:99], v[92:95], v[52:55], v[96:99]
  s_waitcnt lgkmcnt(4)
  v_mfma_f32_16x16x32_bf16 v[96:99], v[100:103], v[56:59], v[96:99]
  s_waitcnt lgkmcnt(2)
  v_mfma_f32_16x16x32_bf16 v[96:99], v[104:107], v[60:63], v[96:99]
  s_waitcnt lgkmcnt(0)
  v_mfma_f32_16x16x32_bf16 v[96:99], v[80:83], v[64:67], v[96:99]
  s_barrier
  ds_read_b64_tr_b16 v[84:85], v15 offset:40960
  ds_read_b64_tr_b16 v[86:87], v15 offset:45056
  ds_read_b64_tr_b16 v[88:89], v15 offset:49152
  ds_read_b64_tr_b16 v[90:91], v15 offset:53248
  ds_read_b64_tr_b16 v[92:93], v15 offset:57344
  ds_read_b64_tr_b16 v[94:95], v15 offset:61440
  s_waitcnt lgkmcnt(4)
  v_mfma_f32_16x16x32_bf16 v[96:99], v[84:87], v[68:71], v[96:99]
  s_waitcnt lgkmcnt(2)
  v_mfma_f32_16x16x32_bf16 v[96:99], v[88:91], v[72:75], v[96:99]
  s_waitcnt lgkmcnt(0)
  v_mfma_f32_16x16x32_bf16 v[96:99], v[92:95], v[76:79], v[96:99]
  s_mov_b64 exec, s[54:55]
  s_nop 6
  v_and_or_b32 v96, v96, v123, s60
  v_and_or_b32 v97, v97, v123, s61
  v_and_or_b32 v98, v98, v123, s62
  v_and_or_b32 v99, v99, v123, s63
  s_cmp_lg_u32 s45, 0
  s_cbranch_scc1 L_ms2
  global_store_dwordx4 v112, v[96:99], s[26:27] sc1
  s_branch L_me2
L_ms2:
  global_store_dwordx4 v112, v[96:99], s[68:69]
L_me2:
  s_mov_b64 exec, -1
  global_load_dwordx4 v[16:19], v113, s[26:27] sc1
  global_load_dwordx4 v[20:23], v122, s[26:27] sc1
  s_mov_b32 s56, 2000000
  s_mov_b64 s[46:47], -1
  s_mov_b64 s[48:49], -1
  s_barrier
  ds_read_b64 v[24:25], v114
  ds_read_b128 v[56:59], v117 offset:0
  ds_read_b128 v[60:63], v117 offset:64
L_p1:
  s_waitcnt vmcnt(0) lgkmcnt(0)
  s_mov_b64 exec, s[46:47]
  v_xor_b32 v16, s60, v16
  v_xor_b32 v17, s61, v17
  v_xor_b32 v18, s62, v18
  v_xor_b32 v19, s63, v19
  v_or3_b32 v28, v16, v17, v18
  v_or_b32 v28, v28, v19
  v_and_b32 v28, 1023, v28
  v_cmp_ne_u32 s[46:47], 0, v28
  s_mov_b64 exec, s[48:49]
  v_xor_b32 v20, s60, v20
  v_xor_b32 v21, s61, v21
  v_xor_b32 v22, s62, v22
  v_xor_b32 v23, s63, v23
  v_or3_b32 v29, v20, v21, v22
  v_or_b32 v29, v29, v23
  v_and_b32 v29, 1023, v29
  v_cmp_ne_u32 s[48:49], 0, v29
  s_or_b64 vcc, s[46:47], s[48:49]
  s_cbranch_scc0 L_p1g
  s_mov_b64 exec, s[46:47]
  s_cbranch_execz L_p1a
  global_load_dwordx4 v[16:19], v113, s[26:27] sc1
L_p1a:
  s_mov_b64 exec, s[48:49]
  s_cbranch_execz L_p1b
  global_load_dwordx4 v[20:23], v122, s[26:27] sc1
L_p1b:
  s_sub_u32 s56, s56, 1
  s_cbranch_scc0 L_p1
  s_waitcnt vmcnt(0)
L_p1g:
  s_mov_b64 exec, -1
  v_mul_f32 v16, v24, v16
  v_mul_f32 v17, v24, v17
  v_mul_f32 v18, v24, v18
  v_mul_f32 v19, v24, v19
  v_fmac_f32 v16, v25, v20
  v_fmac_f32 v17, v25, v21
  v_fmac_f32 v18, v25, v22
  v_fmac_f32 v19, v25, v23
  s_nop 0
  v_permlane32_swap_b32 v16, v18
  v_permlane32_swap_b32 v17, v19
  s_nop 0
  v_add_f32 v16, v16, v18
  v_add_f32 v17, v17, v19
  s_nop 1
  v_permlane16_swap_b32 v16, v17
  s_nop 0
  v_add_f32 v16, v16, v17
  v_cvt_pk_bf16_f32 v16, v16, v16
  ds_write_b16 v115, v16
  s_cmp_ge_u32 s34, 4
  s_waitcnt lgkmcnt(0)
  s_barrier
  s_cbranch_scc1 L_end
  ds_read_b128 v[88:91], v8 offset:1536
  ds_read_b64_tr_b16 v[32:33], v116 offset:0
  ds_read_b64_tr_b16 v[34:35], v116 offset:2048
  ds_read_b128 v[92:95], v8 offset:1600
  ds_read_b64_tr_b16 v[36:37], v116 offset:4096
  ds_read_b64_tr_b16 v[38:39], v116 offset:6144
  ds_read_b128 v[96:99], v8 offset:1664
  ds_read_b64_tr_b16 v[40:41], v116 offset:8192
  ds_read_b64_tr_b16 v[42:43], v116 offset:10240
  ds_read_b128 v[100:103], v8 offset:1728
  ds_read_b64_tr_b16 v[44:45], v116 offset:12288
  ds_read_b64_tr_b16 v[46:47], v116 offset:14336
  s_cmp_ge_u32 s30, 28
  s_cbranch_scc1 L_nf7
  s_waitcnt lgkmcnt(9)
  v_mfma_f32_16x16x32_bf16 v[64:67], v[32:35], v[88:91], 0
  ds_read_b64_tr_b16 v[48:49], v116 offset:16384
  ds_read_b64_tr_b16 v[50:51], v116 offset:18432
  ds_read_b64_tr_b16 v[52:53], v116 offset:20480
  ds_read_b64_tr_b16 v[54:55], v116 offset:22528
  s_waitcnt lgkmcnt(10)
  v_mfma_f32_16x16x32_bf16 v[64:67], v[36:39], v[92:95], v[64:67]
  s_waitcnt lgkmcnt(7)
  v_mfma_f32_16x16x32_bf16 v[64:67], v[40:43], v[96:99], v[64:67]
  s_waitcnt lgkmcnt(4)
  v_mfma_f32_16x16x32_bf16 v[64:67], v[44:47], v[100:103], v[64:67]
  s_waitcnt lgkmcnt(2)
  v_mfma_f32_16x16x32_bf16 v[64:67], v[48:51], v[56:59], v[64:67]
  s_waitcnt lgkmcnt(0)
  v_mfma_f32_16x16x32_bf16 v[64:67], v[52:55], v[60:63], v[64:67]
  s_branch L_nf8
L_nf7:
  s_waitcnt lgkmcnt(9)
  v_mfma_f32_16x16x32_bf16 v[64:67], v[32:35], v[88:91], 0
  s_waitcnt lgkmcnt(6)
  v_mfma_f32_16x16x32_bf16 v[64:67], v[36:39], v[92:95], v[64:67]
  s_waitcnt lgkmcnt(3)
  v_mfma_f32_16x16x32_bf16 v[64:67], v[40:43], v[96:99], v[64:67]
  s_waitcnt lgkmcnt(0)
  v_mfma_f32_16x16x32_bf16 v[64:67], v[44:47], v[100:103], v[64:67]
L_nf8:
  s_mov_b64 exec, s[54:55]
  s_nop 6
  v_and_or_b32 v64, v64, v123, s60
  v_and_or_b32 v65, v65, v123, s61
  v_and_or_b32 v66, v66, v123, s62
  v_and_or_b32 v67, v67, v123, s63
  global_store_dwordx4 v118, v[64:67], s[26:27] sc1
L_end:
  s_endpgm
L_codeend:
.section .rodata,"a"
.p2align 6
.amdhsa_kernel parallel_sum__gqa_block_cached__glu_gated_bilinear__decode_kernel
  .amdhsa_next_free_vgpr 128
  .amdhsa_next_free_sgpr 96
  .amdhsa_accum_offset 128
  .amdhsa_group_segment_fixed_size 0
  .amdhsa_kernarg_size 96
  .amdhsa_user_sgpr_count 2
  .amdhsa_user_sgpr_kernarg_segment_ptr 1
  .amdhsa_system_sgpr_workgroup_id_x 1
  .amdhsa_float_denorm_mode_32 3
.end_amdhsa_kernel
```
